```python
import torch

def _softmax(x, axis=-1):
    return torch.softmax(x, dim=axis)
def _gelu(x):
    return torch.nn.functional.gelu(x, approximate="tanh")
def _silu(x):
    return torch.nn.functional.silu(x)
def _sigmoid(x):
    return torch.sigmoid(x)
def _layernorm(x, axis=-1, eps=1e-5):
    m = x.mean(dim=axis, keepdim=True)
    v = x.var(dim=axis, keepdim=True, unbiased=False)
    return (x - m) / torch.sqrt(v + eps)
def _scatter_add(tgt, idx, src, axis=0):
    return tgt.clone().index_add_(axis, idx, src)
def _segment_sum(src, seg, n):
    out = torch.zeros((n,) + src.shape[1:], dtype=src.dtype)
    return out.index_add_(0, seg, src)
def _pad(x, pw):
    flat = tuple(v for pair in reversed(pw) for v in pair)
    return torch.nn.functional.pad(x, flat)

kernel_name = 'standalone__sliding_block_cached__sampling'

def setup_inputs():

    _w = (lambda a: (lambda t: t.to(torch.bfloat16) if t.is_floating_point() else t)(torch.as_tensor(a)))
    B, Sq, D = 32, 1, 512
    Hq, Hkv, Sk, Dh = 32, 8, 2048, 128
    assert Hq % Hkv == 0, (Hq, Hkv)
    return {
        "x": _w((lambda *s: torch.randn(*s, dtype=torch.bfloat16) * 0.8)(B, Sq, D)),
        "k_cache": _w((lambda *s: torch.randn(*s, dtype=torch.bfloat16) * 0.8)(B, Hkv, Sk, Dh)),
        "v_cache": _w((lambda *s: torch.randn(*s, dtype=torch.bfloat16) * 0.05)(B, Hkv, Sk, Dh)),
        "wq": _w((lambda *s: torch.randn(*s, dtype=torch.bfloat16) * 0.8)(D, Hq * Dh) * (D ** -0.5)),
        "wo": _w((lambda *s: torch.randn(*s, dtype=torch.bfloat16) * 0.05)(Hq * Dh, D) * ((Hq * Dh) ** -0.5)),
    }

def reference(x, k_cache, v_cache, wq, wo):
    B, Sq, D = x.shape
    Hq, Dh = 32, 128
    Hkv, Sk = k_cache.shape[1], k_cache.shape[2]
    W = min(4096, max(256, Sk // 4))
    rep = Hq // Hkv
    q = (lambda x, *d: x.permute(*d))((x @ wq).reshape(B, Sq, Hq, Dh), 0, 2, 1, 3)
    k = (lambda x, n, axis: torch.repeat_interleave(x, n, dim=axis))(k_cache[:, :, Sk - W:, :], rep, axis=1)
    v = (lambda x, n, axis: torch.repeat_interleave(x, n, dim=axis))(v_cache[:, :, Sk - W:, :], rep, axis=1)
    scores = torch.einsum("bhqd,bhkd->bhqk", q, k) * (Dh ** -0.5)
    p = _softmax(scores, axis=-1)
    o = torch.einsum("bhqk,bhkd->bhqd", p, v)
    return (lambda x, *d: x.permute(*d))(o, 0, 2, 1, 3).reshape(B, Sq, Hq * Dh) @ wo
```

```asm
; @launch grid=(256,1,1) block=(768,1,1) lds=38400
.amdgcn_target "amdgcn-amd-amdhsa--gfx950"
.text
.p2align 13
.globl standalone__sliding_block_cached__sampling_kernel
.p2align 8
.type standalone__sliding_block_cached__sampling_kernel,@function
standalone__sliding_block_cached__sampling_kernel:
    s_load_dwordx16 s[16:31], s[0:1], 0
    v_lshrrev_b32 v1, 6, v0
    s_cmp_ge_u32 s2, 256
    s_cbranch_scc1 L_end
    v_readfirstlane_b32 s6, v1
    v_and_b32 v0, 63, v0
    s_lshr_b32 s5, s2, 3
    s_cmp_ge_u32 s6, 8
    s_cbranch_scc1 L_helper
    s_mov_b32 s8, 0x2c200c00
    s_mov_b32 s9, 0x6c604c40
    s_mov_b32 s12, 0x18100800
    s_mov_b32 s13, 0x1a120a02
    s_lshl_b32 s11, s6, 3
    s_lshr_b64 s[8:9], s[8:9], s11
    s_and_b32 s11, s2, 56
    s_lshr_b64 s[12:13], s[12:13], s11
    s_and_b32 s11, s5, 24
    s_lshr_b32 s11, 0x5010400, s11
    s_xor_b32 s8, s8, s12
    s_xor_b32 s8, s8, s11
    s_bfe_u32 s11, s2, 0x10001
    s_xor_b32 s8, s8, s11
    s_and_b32 s8, s8, 0x7f
    s_lshl_b32 s10, s2, 9
    s_add_u32 s10, s10, s8
    s_addk_i32 s10, 0x180
    s_lshl_b32 s10, s10, 10
    v_and_b32 v3, 3, v0
    v_bfe_u32 v4, v0, 2, 2
    v_lshrrev_b32 v5, 4, v0
    v_lshlrev_b32 v5, 6, v5
    v_lshl_add_u32 v1, v4, 8, v5
    v_lshl_add_u32 v1, v3, 4, v1
    s_brev_b32 s34, 16
    s_mov_b32 s35, 0x20000
    s_xor_b32 s65, s10, 0x800
    s_xor_b32 s66, s10, 0x4000
    s_waitcnt lgkmcnt(0)
    s_mov_b64 s[32:33], s[18:19]
    buffer_load_dwordx4 v[8:11], v1, s[32:35], s10 offen nt
    buffer_load_dwordx4 v[12:15], v1, s[32:35], s65 offen nt
    buffer_load_dwordx4 v[16:19], v1, s[32:35], s66 offen nt
    v_lshlrev_b32 v2, 4, v0
    s_mov_b64 s[36:37], s[20:21]
    s_mov_b32 s38, 0x8000000
    s_mov_b32 s39, 0x20000
    v_mov_b32 v4, 0
    v_mov_b32 v5, 0
    v_mov_b32 v6, 0
    v_mov_b32 v7, 0
    s_getreg_b32 s11, hwreg(HW_REG_XCC_ID, 0, 1)
    s_cmp_lg_u32 s11, 0
    s_cselect_b64 vcc, -1, 0
    ds_write_b128 v4, v[4:7]
    ds_write_b128 v4, v[4:7] offset:16
    s_xor_b32 s67, s10, 0x4800
    s_xor_b32 s68, s10, 0x2000
    s_xor_b32 s69, s10, 0x2800
    s_xor_b32 s70, s10, 0x6000
    s_xor_b32 s71, s10, 0x6800
    s_xor_b32 s72, s10, 0x400
    s_xor_b32 s73, s10, 0xc00
    s_xor_b32 s74, s10, 0x4400
    s_xor_b32 s75, s10, 0x4c00
    s_xor_b32 s76, s10, 0x2400
    s_xor_b32 s77, s10, 0x2c00
    s_xor_b32 s78, s10, 0x6400
    s_xor_b32 s79, s10, 0x6c00
    s_waitcnt lgkmcnt(0)
    s_barrier
    s_waitcnt vmcnt(2)
    s_cbranch_vccnz L_thr3
    s_waitcnt vmcnt(1)
L_thr3:
    buffer_load_dwordx4 v[20:23], v1, s[32:35], s67 offen nt
    s_waitcnt vmcnt(2)
    s_cbranch_vccnz L_thr4
    s_waitcnt vmcnt(1)
L_thr4:
    buffer_load_dwordx4 v[24:27], v1, s[32:35], s68 offen nt
    s_waitcnt vmcnt(2)
    s_cbranch_vccnz L_thr5
    s_waitcnt vmcnt(1)
L_thr5:
    buffer_load_dwordx4 v[28:31], v1, s[32:35], s69 offen nt
    s_waitcnt vmcnt(2)
    s_cbranch_vccnz L_thr6
    s_waitcnt vmcnt(1)
L_thr6:
    buffer_load_dwordx4 v[32:35], v1, s[32:35], s70 offen nt
    s_waitcnt vmcnt(2)
    s_cbranch_vccnz L_thr7
    s_waitcnt vmcnt(1)
L_thr7:
    buffer_load_dwordx4 v[36:39], v1, s[32:35], s71 offen nt
    s_waitcnt vmcnt(2)
    s_cbranch_vccnz L_thr8
    s_waitcnt vmcnt(1)
L_thr8:
    buffer_load_dwordx4 v[40:43], v1, s[32:35], s72 offen nt
    s_waitcnt vmcnt(2)
    s_cbranch_vccnz L_thr9
    s_waitcnt vmcnt(1)
L_thr9:
    buffer_load_dwordx4 v[44:47], v1, s[32:35], s73 offen nt
    s_waitcnt vmcnt(2)
    buffer_load_dwordx4 v[48:51], v1, s[32:35], s74 offen nt
    s_waitcnt vmcnt(2)
    buffer_load_dwordx4 v[52:55], v1, s[32:35], s75 offen nt
    s_waitcnt vmcnt(2)
    buffer_load_dwordx4 v[56:59], v1, s[32:35], s76 offen nt
    s_waitcnt vmcnt(2)
    buffer_load_dwordx4 v[60:63], v1, s[32:35], s77 offen nt
    s_waitcnt vmcnt(2)
    buffer_load_dwordx4 v[64:67], v1, s[32:35], s78 offen nt
    s_waitcnt vmcnt(2)
    buffer_load_dwordx4 v[68:71], v1, s[32:35], s79 offen nt
    s_waitcnt vmcnt(2)
    buffer_load_dwordx4 v[72:75], v2, s[36:39], s10 offen nt
    s_waitcnt vmcnt(2)
    buffer_load_dwordx4 v[76:79], v2, s[36:39], s65 offen nt
    s_waitcnt vmcnt(2)
    buffer_load_dwordx4 v[80:83], v2, s[36:39], s66 offen nt
    s_waitcnt vmcnt(2)
    buffer_load_dwordx4 v[84:87], v2, s[36:39], s67 offen nt
    s_waitcnt vmcnt(2)
    buffer_load_dwordx4 v[88:91], v2, s[36:39], s68 offen nt
    s_waitcnt vmcnt(2)
    buffer_load_dwordx4 v[92:95], v2, s[36:39], s69 offen nt
    s_waitcnt vmcnt(2)
    buffer_load_dwordx4 v[96:99], v2, s[36:39], s70 offen nt
    s_mov_b32 s15, 0x40000
    s_mov_b32 s8, 0x05040100
    s_mov_b32 s9, 0x07060302
    s_mov_b32 s14, 0x3e0293ee
L_tq:
    ds_read_b32 v6, v4 offset:4
    s_waitcnt lgkmcnt(0)
    v_readfirstlane_b32 s11, v6
    s_cmp_ge_u32 s11, 1
    s_cbranch_scc1 L_tq_done
    s_sleep 1
    s_sub_u32 s15, s15, 1
    s_cbranch_scc0 L_tq
    s_endpgm
L_tq_done:
    ds_read_b128 v[136:139], v2 offset:512
    s_cmp_ge_u32 s15, 0x40000
    s_cselect_b64 vcc, -1, 0
    s_waitcnt vmcnt(7) lgkmcnt(0)
    v_mfma_f32_16x16x32_bf16 v[140:143], v[8:11], v[136:139], 0
    s_mov_b32 s48, 0x000f000f
    s_mov_b32 s49, 0x000f000f
    v_mfma_f32_16x16x32_bf16 v[8:11], v[12:15], v[136:139], 0
    s_mov_b32 s50, 0x00f000f0
    s_mov_b32 s51, 0x00f000f0
    v_mfma_f32_16x16x32_bf16 v[12:15], v[16:19], v[136:139], 0
    s_mov_b32 s52, 0x0f000f00
    s_mov_b32 s53, 0x0f000f00
    v_mfma_f32_16x16x32_bf16 v[16:19], v[20:23], v[136:139], 0
    s_mov_b32 s54, 0xf000f000
    s_mov_b32 s55, 0xf000f000
    v_mfma_f32_16x16x32_bf16 v[20:23], v[24:27], v[136:139], 0
    v_add_f32_dpp v140, v142, v140 row_ror:8 row_mask:0xf bank_mask:0xf
    v_add_f32_dpp v141, v143, v141 row_ror:8 row_mask:0xf bank_mask:0xf
    v_mfma_f32_16x16x32_bf16 v[24:27], v[28:31], v[136:139], 0
    v_add_f32_dpp v8, v10, v8 row_ror:8 row_mask:0xf bank_mask:0xf
    v_add_f32_dpp v9, v11, v9 row_ror:8 row_mask:0xf bank_mask:0xf
    v_add_f32_dpp v144, v141, v140 row_ror:12 row_mask:0xf bank_mask:0x1
    v_mfma_f32_16x16x32_bf16 v[28:31], v[32:35], v[136:139], 0
    v_add_f32_dpp v13, v15, v13 row_ror:8 row_mask:0xf bank_mask:0xf
    v_add_f32_dpp v12, v14, v12 row_ror:8 row_mask:0xf bank_mask:0xf
    v_add_f32_dpp v145, v9, v8 row_ror:12 row_mask:0xf bank_mask:0x1
    v_mfma_f32_16x16x32_bf16 v[32:35], v[36:39], v[136:139], 0
    v_add_f32_dpp v17, v19, v17 row_ror:8 row_mask:0xf bank_mask:0xf
    v_add_f32_dpp v16, v18, v16 row_ror:8 row_mask:0xf bank_mask:0xf
    v_add_f32_dpp v144, v12, v13 row_ror:4 row_mask:0xf bank_mask:0x2
    v_mfma_f32_16x16x32_bf16 v[36:39], v[40:43], v[136:139], 0
    v_add_f32_dpp v22, v20, v22 row_ror:8 row_mask:0xf bank_mask:0xf
    v_add_f32_dpp v23, v21, v23 row_ror:8 row_mask:0xf bank_mask:0xf
    v_add_f32_dpp v145, v16, v17 row_ror:4 row_mask:0xf bank_mask:0x2
    v_mfma_f32_16x16x32_bf16 v[40:43], v[44:47], v[136:139], 0
    v_add_f32_dpp v26, v24, v26 row_ror:8 row_mask:0xf bank_mask:0xf
    v_add_f32_dpp v27, v25, v27 row_ror:8 row_mask:0xf bank_mask:0xf
    v_add_f32_dpp v144, v23, v22 row_ror:12 row_mask:0xf bank_mask:0x4
    v_mfma_f32_16x16x32_bf16 v[44:47], v[48:51], v[136:139], 0
    v_add_f32_dpp v31, v29, v31 row_ror:8 row_mask:0xf bank_mask:0xf
    v_add_f32_dpp v30, v28, v30 row_ror:8 row_mask:0xf bank_mask:0xf
    v_add_f32_dpp v145, v27, v26 row_ror:12 row_mask:0xf bank_mask:0x4
    v_mfma_f32_16x16x32_bf16 v[48:51], v[52:55], v[136:139], 0
    v_add_f32_dpp v35, v33, v35 row_ror:8 row_mask:0xf bank_mask:0xf
    v_add_f32_dpp v34, v32, v34 row_ror:8 row_mask:0xf bank_mask:0xf
    v_add_f32_dpp v144, v30, v31 row_ror:4 row_mask:0xf bank_mask:0x8
    v_mfma_f32_16x16x32_bf16 v[52:55], v[56:59], v[136:139], 0
    v_add_f32_dpp v36, v38, v36 row_ror:8 row_mask:0xf bank_mask:0xf
    v_add_f32_dpp v37, v39, v37 row_ror:8 row_mask:0xf bank_mask:0xf
    v_add_f32_dpp v145, v34, v35 row_ror:4 row_mask:0xf bank_mask:0x8
    v_mfma_f32_16x16x32_bf16 v[56:59], v[60:63], v[136:139], 0
    v_add_f32_dpp v40, v42, v40 row_ror:8 row_mask:0xf bank_mask:0xf
    v_add_f32_dpp v41, v43, v41 row_ror:8 row_mask:0xf bank_mask:0xf
    v_add_f32_dpp v146, v37, v36 row_ror:12 row_mask:0xf bank_mask:0x1
    v_mfma_f32_16x16x32_bf16 v[60:63], v[64:67], v[136:139], 0
    v_add_f32_dpp v45, v47, v45 row_ror:8 row_mask:0xf bank_mask:0xf
    v_add_f32_dpp v44, v46, v44 row_ror:8 row_mask:0xf bank_mask:0xf
    v_add_f32_dpp v147, v41, v40 row_ror:12 row_mask:0xf bank_mask:0x1
    v_mfma_f32_16x16x32_bf16 v[64:67], v[68:71], v[136:139], 0
    v_add_f32_dpp v49, v51, v49 row_ror:8 row_mask:0xf bank_mask:0xf
    v_add_f32_dpp v48, v50, v48 row_ror:8 row_mask:0xf bank_mask:0xf
    v_add_f32_dpp v146, v44, v45 row_ror:4 row_mask:0xf bank_mask:0x2
    v_add_f32_dpp v54, v52, v54 row_ror:8 row_mask:0xf bank_mask:0xf
    v_add_f32_dpp v55, v53, v55 row_ror:8 row_mask:0xf bank_mask:0xf
    v_add_f32_dpp v147, v48, v49 row_ror:4 row_mask:0xf bank_mask:0x2
    v_add_f32_dpp v58, v56, v58 row_ror:8 row_mask:0xf bank_mask:0xf
    v_add_f32_dpp v59, v57, v59 row_ror:8 row_mask:0xf bank_mask:0xf
    v_add_f32_dpp v146, v55, v54 row_ror:12 row_mask:0xf bank_mask:0x4
    v_add_f32_dpp v63, v61, v63 row_ror:8 row_mask:0xf bank_mask:0xf
    v_add_f32_dpp v62, v60, v62 row_ror:8 row_mask:0xf bank_mask:0xf
    v_add_f32_dpp v147, v59, v58 row_ror:12 row_mask:0xf bank_mask:0x4
    v_add_f32_dpp v67, v65, v67 row_ror:8 row_mask:0xf bank_mask:0xf
    v_add_f32_dpp v66, v64, v66 row_ror:8 row_mask:0xf bank_mask:0xf
    v_add_f32_dpp v146, v62, v63 row_ror:4 row_mask:0xf bank_mask:0x8
    s_nop 0
    v_add_f32_dpp v147, v66, v67 row_ror:4 row_mask:0xf bank_mask:0x8
    v_max3_f32 v5, v144, v145, v146
    v_max_f32 v5, v5, v147
    s_lshl_b32 s11, s6, 3
    v_lshl_add_u32 v3, v3, 6, s11
    v_max_f32_dpp v5, v5, v5 row_ror:8 row_mask:0xf bank_mask:0xf
    s_lshl_b32 s11, s6, 11
    v_add_u32 v1, s11, v2
    v_max_f32_dpp v5, v5, v5 row_ror:4 row_mask:0xf bank_mask:0xf
    v_mov_b32 v6, v5
    s_nop 1
    v_permlane32_swap_b32 v5, v6
    v_max_f32 v5, v5, v6
    v_mov_b32 v6, v5
    s_nop 1
    v_permlane16_swap_b32 v5, v6
    v_max_f32 v5, v5, v6
    v_mul_f32 v6, s14, v5
    v_fma_f32 v144, v144, s14, -v6
    v_fma_f32 v145, v145, s14, -v6
    v_fma_f32 v146, v146, s14, -v6
    v_fma_f32 v147, v147, s14, -v6
    v_exp_f32 v144, v144
    v_exp_f32 v145, v145
    v_exp_f32 v146, v146
    v_exp_f32 v147, v147
    v_mov_b32 v150, 1
    v_add_f32 v7, v144, v145
    v_add_f32 v5, v146, v147
    v_add_f32 v7, v7, v5
    v_cvt_pk_bf16_f32 v148, v144, v145
    v_cvt_pk_bf16_f32 v149, v146, v147
    v_add_f32_dpp v7, v7, v7 row_ror:8 row_mask:0xf bank_mask:0xf
    v_cndmask_b32 v8, 0, v148, s[48:49]
    v_cndmask_b32 v13, 0, v148, s[50:51]
    v_add_f32_dpp v7, v7, v7 row_ror:4 row_mask:0xf bank_mask:0xf
    v_mov_b32 v5, v7
    v_cndmask_b32 v18, 0, v148, s[52:53]
    v_cndmask_b32 v23, 0, v148, s[54:55]
    v_permlane32_swap_b32 v7, v5
    v_add_f32 v7, v7, v5
    v_mov_b32 v5, v7
    v_cndmask_b32 v24, 0, v149, s[48:49]
    v_cndmask_b32 v29, 0, v149, s[50:51]
    v_permlane16_swap_b32 v7, v5
    v_add_f32 v7, v7, v5
    ds_write_b64 v3, v[6:7] offset:256
    s_mov_b64 exec, 1
    ds_add_u32 v4, v150 offset:12
    s_mov_b64 exec, -1
    s_waitcnt vmcnt(2)
    buffer_load_dwordx4 v[100:103], v2, s[36:39], s71 offen nt
    s_cbranch_vccnz L_fr8
    s_waitcnt vmcnt(2)
L_fr8:
    buffer_load_dwordx4 v[104:107], v2, s[36:39], s72 offen nt
    s_cbranch_vccnz L_fr9
    s_waitcnt vmcnt(2)
L_fr9:
    buffer_load_dwordx4 v[108:111], v2, s[36:39], s73 offen nt
    s_cbranch_vccnz L_fr10
    s_waitcnt vmcnt(2)
L_fr10:
    buffer_load_dwordx4 v[112:115], v2, s[36:39], s74 offen nt
    buffer_load_dwordx4 v[116:119], v2, s[36:39], s75 offen nt
    buffer_load_dwordx4 v[120:123], v2, s[36:39], s76 offen nt
    buffer_load_dwordx4 v[124:127], v2, s[36:39], s77 offen nt
    buffer_load_dwordx4 v[128:131], v2, s[36:39], s78 offen nt
    buffer_load_dwordx4 v[132:135], v2, s[36:39], s79 offen nt
    s_mov_b64 exec, 1
    ds_add_u32 v4, v150 offset:8
    s_mov_b64 exec, -1
    v_cndmask_b32 v34, 0, v149, s[52:53]
    v_cndmask_b32 v39, 0, v149, s[54:55]
    v_mov_b32_dpp v9, v13 row_ror:12 row_mask:0xf bank_mask:0xf
    v_mov_b32_dpp v10, v18 row_ror:8 row_mask:0xf bank_mask:0xf
    v_mov_b32_dpp v11, v23 row_ror:4 row_mask:0xf bank_mask:0xf
    v_mov_b32_dpp v12, v8 row_ror:4 row_mask:0xf bank_mask:0xf
    v_mov_b32_dpp v14, v18 row_ror:12 row_mask:0xf bank_mask:0xf
    v_mov_b32_dpp v15, v23 row_ror:8 row_mask:0xf bank_mask:0xf
    v_mov_b32_dpp v16, v8 row_ror:8 row_mask:0xf bank_mask:0xf
    v_mov_b32_dpp v17, v13 row_ror:4 row_mask:0xf bank_mask:0xf
    v_mov_b32_dpp v19, v23 row_ror:12 row_mask:0xf bank_mask:0xf
    v_mov_b32_dpp v20, v8 row_ror:12 row_mask:0xf bank_mask:0xf
    v_mov_b32_dpp v21, v13 row_ror:8 row_mask:0xf bank_mask:0xf
    v_mov_b32_dpp v22, v18 row_ror:4 row_mask:0xf bank_mask:0xf
    v_mov_b32_dpp v25, v29 row_ror:12 row_mask:0xf bank_mask:0xf
    v_mov_b32_dpp v26, v34 row_ror:8 row_mask:0xf bank_mask:0xf
    v_mov_b32_dpp v27, v39 row_ror:4 row_mask:0xf bank_mask:0xf
    v_mov_b32_dpp v28, v24 row_ror:4 row_mask:0xf bank_mask:0xf
    v_mov_b32_dpp v30, v34 row_ror:12 row_mask:0xf bank_mask:0xf
    v_mov_b32_dpp v31, v39 row_ror:8 row_mask:0xf bank_mask:0xf
    v_mov_b32_dpp v32, v24 row_ror:8 row_mask:0xf bank_mask:0xf
    v_mov_b32_dpp v33, v29 row_ror:4 row_mask:0xf bank_mask:0xf
    v_mov_b32_dpp v35, v39 row_ror:12 row_mask:0xf bank_mask:0xf
    v_mov_b32_dpp v36, v24 row_ror:12 row_mask:0xf bank_mask:0xf
    v_mov_b32_dpp v37, v29 row_ror:8 row_mask:0xf bank_mask:0xf
    v_mov_b32_dpp v38, v34 row_ror:4 row_mask:0xf bank_mask:0xf
    s_waitcnt vmcnt(14)
    v_perm_b32 v40, v76, v72, s8
    v_perm_b32 v44, v76, v72, s9
    v_perm_b32 v48, v77, v73, s8
    v_perm_b32 v52, v77, v73, s9
    v_perm_b32 v56, v78, v74, s8
    v_perm_b32 v60, v78, v74, s9
    v_perm_b32 v64, v79, v75, s8
    v_perm_b32 v68, v79, v75, s9
    s_waitcnt vmcnt(12)
    v_perm_b32 v41, v84, v80, s8
    v_perm_b32 v45, v84, v80, s9
    v_perm_b32 v49, v85, v81, s8
    v_perm_b32 v53, v85, v81, s9
    v_perm_b32 v57, v86, v82, s8
    v_perm_b32 v61, v86, v82, s9
    v_perm_b32 v65, v87, v83, s8
    v_perm_b32 v69, v87, v83, s9
    s_waitcnt vmcnt(10)
    v_perm_b32 v42, v92, v88, s8
    v_perm_b32 v46, v92, v88, s9
    v_perm_b32 v50, v93, v89, s8
    v_perm_b32 v54, v93, v89, s9
    v_perm_b32 v58, v94, v90, s8
    v_perm_b32 v62, v94, v90, s9
    v_perm_b32 v66, v95, v91, s8
    v_perm_b32 v70, v95, v91, s9
    s_waitcnt vmcnt(8)
    v_perm_b32 v43, v100, v96, s8
    v_perm_b32 v47, v100, v96, s9
    v_perm_b32 v51, v101, v97, s8
    v_mfma_f32_16x16x32_bf16 v[152:155], v[40:43], v[8:11], 0
    v_perm_b32 v55, v101, v97, s9
    v_perm_b32 v59, v102, v98, s8
    v_mfma_f32_16x16x32_bf16 v[152:155], v[44:47], v[12:15], v[152:155]
    v_perm_b32 v63, v102, v98, s9
    v_perm_b32 v67, v103, v99, s8
    v_mfma_f32_16x16x32_bf16 v[152:155], v[48:51], v[16:19], v[152:155]
    v_perm_b32 v71, v103, v99, s9
    v_mfma_f32_16x16x32_bf16 v[152:155], v[52:55], v[20:23], v[152:155]
    v_mfma_f32_16x16x32_bf16 v[156:159], v[56:59], v[8:11], 0
    v_mfma_f32_16x16x32_bf16 v[156:159], v[60:63], v[12:15], v[156:159]
    v_mfma_f32_16x16x32_bf16 v[156:159], v[64:67], v[16:19], v[156:159]
    v_mfma_f32_16x16x32_bf16 v[156:159], v[68:71], v[20:23], v[156:159]
    s_waitcnt vmcnt(6)
    v_perm_b32 v72, v108, v104, s8
    v_perm_b32 v76, v108, v104, s9
    v_perm_b32 v80, v109, v105, s8
    v_perm_b32 v84, v109, v105, s9
    v_perm_b32 v88, v110, v106, s8
    v_perm_b32 v92, v110, v106, s9
    v_perm_b32 v96, v111, v107, s8
    v_perm_b32 v100, v111, v107, s9
    s_waitcnt vmcnt(4)
    v_perm_b32 v73, v116, v112, s8
    v_perm_b32 v77, v116, v112, s9
    v_perm_b32 v81, v117, v113, s8
    v_perm_b32 v85, v117, v113, s9
    v_perm_b32 v89, v118, v114, s8
    v_perm_b32 v93, v118, v114, s9
    v_perm_b32 v97, v119, v115, s8
    v_perm_b32 v101, v119, v115, s9
    s_waitcnt vmcnt(2)
    v_perm_b32 v74, v124, v120, s8
    v_perm_b32 v78, v124, v120, s9
    v_perm_b32 v82, v125, v121, s8
    v_perm_b32 v86, v125, v121, s9
    v_perm_b32 v90, v126, v122, s8
    v_perm_b32 v94, v126, v122, s9
    v_perm_b32 v98, v127, v123, s8
    v_perm_b32 v102, v127, v123, s9
    s_waitcnt vmcnt(0)
    v_perm_b32 v75, v132, v128, s8
    v_perm_b32 v79, v132, v128, s9
    v_perm_b32 v83, v133, v129, s8
    v_mfma_f32_16x16x32_bf16 v[152:155], v[72:75], v[24:27], v[152:155]
    v_perm_b32 v87, v133, v129, s9
    v_perm_b32 v91, v134, v130, s8
    v_mfma_f32_16x16x32_bf16 v[152:155], v[76:79], v[28:31], v[152:155]
    v_perm_b32 v95, v134, v130, s9
    v_perm_b32 v99, v135, v131, s8
    v_mfma_f32_16x16x32_bf16 v[152:155], v[80:83], v[32:35], v[152:155]
    v_perm_b32 v103, v135, v131, s9
    v_mfma_f32_16x16x32_bf16 v[152:155], v[84:87], v[36:39], v[152:155]
    v_mfma_f32_16x16x32_bf16 v[156:159], v[88:91], v[24:27], v[156:159]
    v_mfma_f32_16x16x32_bf16 v[156:159], v[92:95], v[28:31], v[156:159]
    v_mfma_f32_16x16x32_bf16 v[156:159], v[96:99], v[32:35], v[156:159]
    v_mfma_f32_16x16x32_bf16 v[156:159], v[100:103], v[36:39], v[156:159]
    s_nop 3
    ds_write_b128 v1, v[152:155] offset:1536
    s_nop 2
    ds_write_b128 v1, v[156:159] offset:2560
    s_waitcnt lgkmcnt(0)
    s_barrier
    s_endpgm
L_helper:
    s_memrealtime s[98:99]
    s_and_b32 s3, s6, 3
    s_and_b32 s4, s2, 7
    s_lshl_b32 s96, s4, 5
    s_add_u32 s96, s96, s5
    s_lshl_b32 s62, s96, 11
    s_lshl_b32 s96, s96, 10
    s_add_u32 s96, s96, 0x80000
    s_lshr_b32 s6, s5, 3
    s_and_b32 s7, s5, 7
    s_and_b32 s59, s6, 1
    s_lshr_b32 s58, s6, 1
    v_lshrrev_b32 v1, 4, v0
    v_and_b32 v3, 15, v0
    v_lshlrev_b32 v7, 4, v1
    v_lshl_add_u32 v5, v3, 10, v7
    v_lshlrev_b32 v6, 16, v1
    v_lshl_add_u32 v6, v3, 3, v6
    s_lshl_b32 s63, s58, 14
    s_lshl_b32 s11, s59, 9
    s_add_u32 s63, s63, s11
    s_lshl_b32 s10, s3, 7
    s_add_u32 s63, s63, s10
    s_add_u32 s10, s10, s11
    s_lshl_b32 s12, s10, 12
    s_lshl_b32 s11, s4, 10
    s_add_u32 s12, s12, s11
    s_lshl_b32 s14, s7, 7
    s_xor_b32 s11, s14, 512
    s_add_u32 s12, s12, s11
    s_mov_b32 s34, 0x8000
    s_mov_b32 s35, 0x20000
    s_mov_b32 s38, 0x400000
    s_mov_b32 s39, 0x20000
    s_mov_b32 s46, 0x2c2000
    s_mov_b32 s47, 0x20000
    s_mov_b32 s50, 0x100
    s_mov_b32 s51, 0x20000
    v_mov_b32 v144, -1
    v_mov_b32 v145, -1
    v_mov_b32 v146, -1
    v_mov_b32 v147, -1
    v_lshlrev_b32 v155, 4, v0
    s_getreg_b32 s60, hwreg(HW_REG_XCC_ID, 0, 3)
    s_mov_b32 s15, 0x40000
    v_mov_b32 v152, 0
    v_mov_b32 v153, 1
    v_lshlrev_b32 v156, 7, v3
    s_lshl_b32 s56, s5, 2
    s_add_u32 s56, s56, s3
    s_cmp_lt_u32 s3, 2
    s_cselect_b64 vcc, -1, 0
    s_cmp_lg_u32 s3, 0
    s_waitcnt lgkmcnt(0)
    s_mov_b64 s[32:33], s[16:17]
    s_mov_b64 s[36:37], s[22:23]
    s_mov_b64 s[44:45], s[30:31]
    s_mov_b64 s[48:49], s[28:29]
    s_cbranch_scc1 L_noarr
    s_cmp_ge_u32 s2, 8
    s_cbranch_scc1 L_nolead
    s_mul_i32 s99, s98, 0x9e3779b1
    s_lshr_b32 s11, s99, 15
    s_xor_b32 s99, s99, s11
    s_sub_u32 s11, s60, s2
    s_and_b32 s11, s11, 7
    s_or_b32 s11, s11, 0x100
    v_mov_b32 v158, s99
    v_mov_b32 v159, s11
    v_mov_b32 v160, 0
    v_mov_b32 v161, 0
    s_mov_b64 exec, 1
    buffer_atomic_cmpswap_x2 v[158:161], v152, s[48:51], 0 offen sc1
    s_mov_b64 exec, -1
L_nolead:
    buffer_store_dwordx4 v[144:147], v155, s[44:47], s62 offen
    buffer_store_dwordx4 v[144:147], v155, s[44:47], s62 offen offset:1024
    buffer_store_dwordx4 v[144:147], v155, s[44:47], s96 offen
L_noarr:
    s_cmp_lg_u32 s56, 2
    s_cbranch_scc1 L_nocpf
    s_getpc_b64 s[100:101]
L_pc:
    s_sub_u32 s100, s100, L_pc-standalone__sliding_block_cached__sampling_kernel
    s_subb_u32 s101, s101, 0
    v_min_u32 v158, 57, v0
    v_lshlrev_b32 v158, 7, v158
    global_load_dword v154, v158, s[100:101]
L_nocpf:
    s_lshl_b32 s11, s4, 8
    s_add_u32 s86, s30, s11
    s_addc_u32 s87, s31, 0
    buffer_load_dwordx4 v[136:139], v5, s[32:35], s63 offen offset:0
    buffer_load_dwordx4 v[140:143], v5, s[32:35], s63 offen offset:64
    buffer_load_dwordx2 v[8:9], v6, s[36:39], s12 offen nt
    s_add_u32 s11, s12, 8192
    buffer_load_dwordx2 v[10:11], v6, s[36:39], s11 offen nt
    s_add_u32 s11, s12, 16384
    buffer_load_dwordx2 v[12:13], v6, s[36:39], s11 offen nt
    s_add_u32 s11, s12, 24576
    buffer_load_dwordx2 v[14:15], v6, s[36:39], s11 offen nt
    s_setprio 3
    s_barrier
    s_cmp_lg_u32 s56, 3
    s_cbranch_scc1 L_nowarm
    s_load_dword s66, s[86:87], 0xd0000 glc
    s_load_dword s67, s[86:87], 0xd2000 glc
L_nowarm:
    s_waitcnt vmcnt(5)
    s_add_u32 s11, s12, 32768
    buffer_load_dwordx2 v[16:17], v6, s[36:39], s11 offen nt
    s_waitcnt vmcnt(5)
    s_cmp_lg_u32 s3, 0
    s_cbranch_scc1 L_nord
    buffer_load_dwordx2 v[158:159], v152, s[48:51], 0 offen sc1
L_nord:
    s_cmp_lg_u32 s3, 1
    s_cbranch_scc1 L_notlb
    s_lshl_b32 s11, s2, 19
    s_add_u32 s11, s11, 393216
    v_mov_b32 v158, s11
    s_lshl_b32 s11, s4, 19
    v_mov_b32 v159, s11
    s_mov_b64 exec, 1
    global_load_dword v154, v158, s[20:21] nt
    global_load_dword v154, v159, s[24:25] nt
    global_load_dword v154, v152, s[26:27] sc1
    s_mov_b64 exec, -1
L_notlb:
    s_add_u32 s11, s12, 40960
    buffer_load_dwordx2 v[18:19], v6, s[36:39], s11 offen nt
    s_waitcnt vmcnt(7)
    s_cbranch_vccnz L_hx7
    s_waitcnt vmcnt(5)
L_hx7:
    s_add_u32 s11, s12, 49152
    buffer_load_dwordx2 v[20:21], v6, s[36:39], s11 offen nt
    s_waitcnt vmcnt(7)
    s_cbranch_vccnz L_hx8
    s_waitcnt vmcnt(5)
L_hx8:
    s_add_u32 s11, s12, 57344
    buffer_load_dwordx2 v[22:23], v6, s[36:39], s11 offen nt
    s_waitcnt vmcnt(7)
    s_cbranch_vccnz L_hx9
    s_waitcnt vmcnt(5)
L_hx9:
    s_add_u32 s11, s12, 262144
    buffer_load_dwordx2 v[24:25], v6, s[36:39], s11 offen nt
    s_waitcnt vmcnt(7)
    s_cbranch_vccnz L_hx10
    s_waitcnt vmcnt(5)
L_hx10:
    s_add_u32 s11, s12, 270336
    buffer_load_dwordx2 v[26:27], v6, s[36:39], s11 offen nt
    s_cmp_lg_u32 s56, 3
    s_cbranch_scc1 L_noprobe
    s_waitcnt lgkmcnt(0)
    s_memtime s[80:81]
    s_waitcnt lgkmcnt(0)
    s_load_dword s66, s[86:87], 0xd0000 glc
    s_waitcnt lgkmcnt(0)
    s_memtime s[82:83]
    s_waitcnt lgkmcnt(0)
    s_load_dword s67, s[86:87], 0xd2000 glc
    s_waitcnt lgkmcnt(0)
    s_memtime s[84:85]
    s_waitcnt lgkmcnt(0)
    s_sub_u32 s80, s82, s80
    s_sub_u32 s82, s84, s82
    s_cmp_gt_u32 s80, s82
    s_cselect_b32 s11, 17, 16
    s_lshr_b32 s99, s60, 2
    s_xor_b32 s11, s11, s99
    v_mov_b32 v158, s11
    v_mov_b32 v159, 0
    s_mov_b64 exec, 1
    buffer_atomic_cmpswap v[158:159], v152, s[48:51], 0 offen offset:128 sc1
    s_mov_b64 exec, -1
L_noprobe:
    s_waitcnt vmcnt(7)
    s_cbranch_vccnz L_hx11
    s_waitcnt vmcnt(5)
L_hx11:
    s_add_u32 s11, s12, 278528
    buffer_load_dwordx2 v[28:29], v6, s[36:39], s11 offen nt
    s_waitcnt vmcnt(7)
    s_cbranch_vccnz L_hx12
    s_waitcnt vmcnt(5)
L_hx12:
    s_cmp_lg_u32 s3, 0
    s_cbranch_scc1 L_nochk
    s_waitcnt vmcnt(6)
    s_branch L_gc
L_gc_again:
    buffer_load_dwordx2 v[158:159], v152, s[48:51], 0 offen sc1
    s_waitcnt vmcnt(0)
L_gc:
    v_readfirstlane_b32 s11, v159
    s_cmp_lg_u32 s11, 0
    s_cbranch_scc1 L_gc_done
    s_sub_u32 s15, s15, 1
    s_cbranch_scc0 L_gc_again
    s_endpgm
L_gc_done:
    s_and_b32 s99, s11, 7
    s_add_u32 s11, s11, s2
    s_and_b32 s11, s11, 7
    s_lshr_b32 s97, s62, 4
    s_add_u32 s97, s97, 0xc0000
    s_cmp_eq_u32 s11, s60
    s_cselect_b32 s57, 1, 0
    s_mov_b64 exec, 1
    s_cbranch_scc1 L_fl
    v_xor_b32 v159, 1, v158
    buffer_store_dword v159, v152, s[44:47], s97 offen sc1
    s_branch L_fg
L_fl:
    buffer_store_dword v158, v152, s[44:47], s97 offen
L_fg:
    s_mov_b64 exec, -1
    s_andn2_b32 s97, s97, 0x7ff
L_nochk:
    s_add_u32 s11, s12, 286720
    buffer_load_dwordx2 v[30:31], v6, s[36:39], s11 offen nt
    s_waitcnt vmcnt(7)
    s_cbranch_vccnz L_hx13
    s_waitcnt vmcnt(5)
L_hx13:
    s_add_u32 s11, s12, 294912
    buffer_load_dwordx2 v[32:33], v6, s[36:39], s11 offen nt
    s_waitcnt vmcnt(7)
    s_cbranch_vccnz L_hx14
    s_waitcnt vmcnt(5)
L_hx14:
    s_add_u32 s11, s12, 303104
    buffer_load_dwordx2 v[34:35], v6, s[36:39], s11 offen nt
    s_waitcnt vmcnt(7)
    s_cbranch_vccnz L_hx15
    s_waitcnt vmcnt(5)
L_hx15:
    s_add_u32 s11, s12, 311296
    buffer_load_dwordx2 v[36:37], v6, s[36:39], s11 offen nt
    s_waitcnt vmcnt(7)
    s_cbranch_vccnz L_hx16
    s_waitcnt vmcnt(5)
L_hx16:
    s_add_u32 s11, s12, 319488
    buffer_load_dwordx2 v[38:39], v6, s[36:39], s11 offen nt
    s_cmp_lg_u32 s3, 0
    s_cbranch_scc1 L_nofr
    buffer_load_dword v159, v156, s[44:47], s97 offen sc1
L_nofr:
    s_mov_b32 s8, 0x05040100
    s_mov_b32 s9, 0x07060302
    s_mov_b64 s[52:53], s[26:27]
    s_mov_b32 s54, 0x8000
    s_mov_b32 s55, 0x20000
    s_mov_b64 s[40:41], s[24:25]
    s_mov_b32 s42, 0x400000
    s_mov_b32 s43, 0x20000
    v_and_b32 v4, 1, v1
    v_lshlrev_b32 v4, 8, v4
    v_lshrrev_b32 v2, 1, v1
    v_add_u32 v4, v4, v2
    v_lshlrev_b32 v4, 10, v4
    v_lshl_add_u32 v4, v3, 3, v4
    s_lshl_b32 s13, s4, 19
    s_add_u32 s13, s13, s14
    s_lshl_b32 s11, s3, 15
    s_add_u32 s13, s13, s11
    s_lshl_b32 s11, s59, 12
    s_add_u32 s13, s13, s11
    s_andn2_b32 s96, s96, 0x3fff
    s_lshl_b32 s10, s10, 4
    s_add_u32 s10, s10, s96
    s_andn2_b32 s63, s62, 0x7fff
    s_lshl_b32 s11, s3, 13
    s_add_u32 s63, s63, s11
    s_lshl_b32 s11, s59, 10
    s_add_u32 s63, s63, s11
    s_xor_b32 s11, s14, 512
    s_add_u32 s63, s63, s11
    v_lshlrev_b32 v162, 11, v1
    v_lshl_add_u32 v162, v3, 3, v162
    s_lshl_b32 s11, s3, 12
    s_add_u32 s96, s96, s11
    s_and_b32 s11, s5, 15
    s_lshl_b32 s11, s11, 4
    s_add_u32 s96, s96, s11
    v_lshlrev_b32 v160, 6, v0
    s_lshl_b32 s12, s6, 3
    s_add_u32 s12, s12, s4
    s_lshl_b32 s12, s12, 10
    s_add_u32 s12, s12, s14
    s_lshl_b32 s56, s58, 4
    s_lshr_b32 s11, s3, 1
    s_lshl_b32 s11, s11, 3
    s_add_u32 s56, s56, s11
    s_add_u32 s56, s56, s7
    s_andn2_b32 s14, s56, 2
    s_lshl_b32 s14, s14, 12
    s_and_b32 s11, s56, 2
    s_lshl_b32 s11, s11, 18
    s_add_u32 s14, s14, s11
    s_add_u32 s14, s14, 0x100000
    s_lshl_b32 s11, s4, 1
    s_add_u32 s61, s11, s58
    s_add_u32 s11, s11, s59
    s_lshl_b32 s11, s11, 8
    s_add_u32 s14, s14, s11
    s_lshl_b32 s61, s61, 8
    s_mov_b32 s58, 0x11111111
    s_mov_b32 s59, 0x11111111
    v_mul_u32_u24 v149, 288, v1
    v_lshl_add_u32 v149, v3, 4, v149
    s_mul_i32 s11, s3, 5120
    v_add_u32 v149, s11, v149
    v_bfe_u32 v163, v0, 2, 2
    v_mul_u32_u24 v150, 288, v163
    v_add_u32 v150, v150, v7
    v_and_b32 v151, 3, v0
    v_lshl_add_u32 v150, v151, 2, v150
    s_lshl_b32 s11, s3, 6
    s_add_u32 s11, s11, 17920
    v_add_u32 v150, s11, v150
    v_perm_b32 v72, v10, v8, s8
    v_perm_b32 v76, v10, v8, s9
    v_perm_b32 v80, v11, v9, s8
    v_perm_b32 v84, v11, v9, s9
    v_perm_b32 v73, v14, v12, s8
    v_perm_b32 v77, v14, v12, s9
    v_perm_b32 v81, v15, v13, s8
    v_perm_b32 v85, v15, v13, s9
    v_perm_b32 v74, v18, v16, s8
    v_perm_b32 v78, v18, v16, s9
    v_perm_b32 v82, v19, v17, s8
    v_perm_b32 v86, v19, v17, s9
    v_perm_b32 v75, v22, v20, s8
    v_perm_b32 v79, v22, v20, s9
    v_perm_b32 v83, v23, v21, s8
    v_perm_b32 v87, v23, v21, s9
    s_waitcnt vmcnt(6)
    v_perm_b32 v88, v26, v24, s8
    v_perm_b32 v92, v26, v24, s9
    v_perm_b32 v96, v27, v25, s8
    v_perm_b32 v100, v27, v25, s9
    s_waitcnt vmcnt(4)
    v_perm_b32 v89, v30, v28, s8
    v_perm_b32 v93, v30, v28, s9
    v_perm_b32 v97, v31, v29, s8
    v_perm_b32 v101, v31, v29, s9
    s_waitcnt vmcnt(2)
    v_perm_b32 v90, v34, v32, s8
    v_perm_b32 v94, v34, v32, s9
    v_perm_b32 v98, v35, v33, s8
    v_perm_b32 v102, v35, v33, s9
    s_waitcnt vmcnt(0)
    v_perm_b32 v91, v38, v36, s8
    v_perm_b32 v95, v38, v36, s9
    v_perm_b32 v99, v39, v37, s8
    v_perm_b32 v103, v39, v37, s9
    v_mfma_f32_16x16x32_bf16 v[8:11], v[72:75], v[136:139], 0
    v_mfma_f32_16x16x32_bf16 v[12:15], v[76:79], v[136:139], 0
    v_mfma_f32_16x16x32_bf16 v[16:19], v[80:83], v[136:139], 0
    v_mfma_f32_16x16x32_bf16 v[20:23], v[84:87], v[136:139], 0
    v_mfma_f32_16x16x32_bf16 v[8:11], v[88:91], v[140:143], v[8:11]
    v_mfma_f32_16x16x32_bf16 v[12:15], v[92:95], v[140:143], v[12:15]
    v_mfma_f32_16x16x32_bf16 v[16:19], v[96:99], v[140:143], v[16:19]
    v_mfma_f32_16x16x32_bf16 v[20:23], v[100:103], v[140:143], v[20:23]
    s_nop 4
    ds_write_b128 v149, v[8:11] offset:17920
    ds_write_b128 v149, v[12:15] offset:19200
    ds_write_b128 v149, v[16:19] offset:20480
    ds_write_b128 v149, v[20:23] offset:21760
    s_cmp_lg_u32 s3, 0
    s_cbranch_scc1 L_nov
    s_cmp_eq_u32 s57, 0
    s_cbranch_scc0 L_ar
    s_branch L_ar_done
L_ar_again:
    buffer_load_dword v159, v156, s[44:47], s97 offen sc1
L_ar:
    s_waitcnt vmcnt(0)
    v_xor_b32 v159, v159, v158
    v_cmp_lt_u32 vcc, 1, v159
    s_cbranch_vccz L_ar_ok
    s_sub_u32 s15, s15, 1
    s_cbranch_scc0 L_ar_again
    s_endpgm
L_ar_ok:
    v_cmp_ne_u32 vcc, 0, v159
    s_nop 0
    s_cmp_eq_u64 vcc, 0
    s_cselect_b32 s57, 1, 0
L_ar_done:
    s_lshl_b32 s11, s99, 1
    s_or_b32 s11, s11, s57
    v_mov_b32 v159, s11
    ds_write_b64 v152, v[158:159] offset:16
L_nov:
    s_mov_b64 exec, 1
    ds_add_u32 v152, v153 offset:0
    s_mov_b64 exec, -1
    v_mov_b32 v148, 0xff
L_hs:
    ds_read_b32 v154, v152 offset:0
    s_waitcnt lgkmcnt(0)
    v_readfirstlane_b32 s11, v154
    s_cmp_ge_u32 s11, 4
    s_cbranch_scc1 L_hs_done
    s_sub_u32 s15, s15, 1
    s_cbranch_scc0 L_hs
    s_endpgm
L_hs_done:
    ds_read_b64 v[158:159], v152 offset:16
    ds_read2st64_b32 v[24:25], v150 offset0:0 offset1:5
    ds_read2st64_b32 v[26:27], v150 offset0:10 offset1:15
    ds_read2st64_b32 v[28:29], v150 offset0:20 offset1:25
    ds_read2st64_b32 v[30:31], v150 offset0:30 offset1:35
    ds_read2st64_b32 v[32:33], v150 offset0:40 offset1:45
    ds_read2st64_b32 v[34:35], v150 offset0:50 offset1:55
    ds_read2st64_b32 v[36:37], v150 offset0:60 offset1:65
    ds_read2st64_b32 v[38:39], v150 offset0:70 offset1:75
    s_waitcnt lgkmcnt(4)
    v_pk_add_f32 v[24:25], v[24:25], v[28:29]
    v_pk_add_f32 v[26:27], v[26:27], v[30:31]
    s_waitcnt lgkmcnt(2)
    v_pk_add_f32 v[24:25], v[24:25], v[32:33]
    v_pk_add_f32 v[26:27], v[26:27], v[34:35]
    s_waitcnt lgkmcnt(0)
    v_pk_add_f32 v[24:25], v[24:25], v[36:37]
    v_pk_add_f32 v[26:27], v[26:27], v[38:39]
    v_mov_b32 v156, v158
    v_readfirstlane_b32 s101, v158
    v_readfirstlane_b32 s57, v159
    v_cvt_pk_bf16_f32 v164, v24, v25
    v_cvt_pk_bf16_f32 v165, v26, v27
    v_min_u32 v164, -2, v164
    v_min_u32 v165, -2, v165
    s_and_b32 s98, s101, 0xff
    s_bfe_u32 s99, s101, 0x80008
    s_bfe_u32 s100, s101, 0x80010
    s_lshr_b32 s101, s101, 24
    v_mov_b32_dpp v166, v164 quad_perm:[1,1,3,3] row_mask:0xf bank_mask:0xf
    v_mov_b32_dpp v167, v165 quad_perm:[1,1,3,3] row_mask:0xf bank_mask:0xf
    s_mov_b32 exec_lo, 0x55555555
    s_mov_b32 exec_hi, 0x55555555
    s_lshr_b32 s60, s57, 1
    s_and_b32 s57, s57, 1
    s_cbranch_scc0 L_qslow
    buffer_store_dwordx4 v[164:167], v162, s[44:47], s63 offen
    s_mov_b64 exec, -1
L_qg:
    buffer_load_dwordx2 v[40:41], v4, s[40:43], s13 offen offset:0 nt
    s_add_u32 s11, s13, 8192
    buffer_load_dwordx2 v[42:43], v4, s[40:43], s11 offen offset:0 nt
    s_add_u32 s11, s13, 16384
    buffer_load_dwordx2 v[44:45], v4, s[40:43], s11 offen offset:0 nt
    s_add_u32 s11, s13, 24576
    buffer_load_dwordx2 v[46:47], v4, s[40:43], s11 offen offset:0 nt
    s_cmp_lg_u32 s3, 0
    s_cbranch_scc1 L_noq
    v_lshl_add_u32 v157, v3, 6, v7
L_qp:
    buffer_load_dwordx4 v[8:11], v155, s[44:47], s62 offen sc1
    buffer_load_dwordx4 v[12:15], v155, s[44:47], s62 offen offset:1024 sc1
    buffer_load_dword v26, v152, s[48:51], 0 offen offset:128 sc1
    s_waitcnt vmcnt(0)
    v_add_u32 v25, -1, v26
    v_max3_u32 v16, v8, v9, v10
    v_max3_u32 v17, v11, v12, v13
    v_max3_u32 v16, v16, v14, v15
    v_max3_u32 v16, v16, v17, v25
    v_cmp_eq_u32 vcc, -1, v16
    s_cbranch_vccz L_qp_done
    s_sub_u32 s15, s15, 1
    s_cbranch_scc0 L_qp
    s_endpgm
L_qp_done:
    v_lshlrev_b32 v16, 16, v8
    v_lshlrev_b32 v18, 16, v12
    v_and_b32 v17, 0xffff0000, v8
    v_and_b32 v19, 0xffff0000, v12
    v_pk_add_f32 v[16:17], v[16:17], v[18:19]
    v_cvt_pk_bf16_f32 v20, v16, v17
    v_lshlrev_b32 v16, 16, v9
    v_lshlrev_b32 v18, 16, v13
    v_and_b32 v17, 0xffff0000, v9
    v_and_b32 v19, 0xffff0000, v13
    v_pk_add_f32 v[16:17], v[16:17], v[18:19]
    v_cvt_pk_bf16_f32 v21, v16, v17
    v_lshlrev_b32 v16, 16, v10
    v_lshlrev_b32 v18, 16, v14
    v_and_b32 v17, 0xffff0000, v10
    v_and_b32 v19, 0xffff0000, v14
    v_pk_add_f32 v[16:17], v[16:17], v[18:19]
    v_cvt_pk_bf16_f32 v22, v16, v17
    v_lshlrev_b32 v16, 16, v11
    v_lshlrev_b32 v18, 16, v15
    v_and_b32 v17, 0xffff0000, v11
    v_and_b32 v19, 0xffff0000, v15
    v_pk_add_f32 v[16:17], v[16:17], v[18:19]
    v_cvt_pk_bf16_f32 v23, v16, v17
    ds_write_b128 v157, v[20:23] offset:512
    ds_write_b32 v152, v26 offset:24
    ds_write_b32 v152, v153 offset:4
L_noq:
    s_setprio 0
    s_lshl_b32 s11, s3, 9
    v_lshl_add_u32 v6, v0, 3, s11
    v_bfe_u32 v7, v0, 1, 2
    v_lshlrev_b32 v7, 6, v7
    v_mul_u32_u24 v149, 272, v3
    v_lshl_add_u32 v149, v1, 4, v149
    s_mul_i32 s11, s3, 4352
    v_add_u32 v149, s11, v149
    v_mul_u32_u24 v150, 272, v1
    v_lshl_add_u32 v150, v3, 4, v150
    s_mul_i32 s11, s3, 1088
    v_add_u32 v150, s11, v150
    v_lshlrev_b32 v158, 5, v151
    v_lshl_add_u32 v158, v1, 3, v158
    v_lshl_add_u32 v158, v163, 1, v158
    s_andn2_b32 s62, s5, 2
    s_lshl_b32 s62, s62, 12
    s_and_b32 s11, s5, 2
    s_lshl_b32 s11, s11, 18
    s_add_u32 s62, s62, s11
    s_add_u32 s62, s62, 0x100000
    s_waitcnt vmcnt(0)
    v_perm_b32 v104, v42, v40, s8
    v_perm_b32 v108, v42, v40, s9
    v_perm_b32 v112, v43, v41, s8
    v_perm_b32 v116, v43, v41, s9
    v_perm_b32 v105, v46, v44, s8
    v_perm_b32 v109, v46, v44, s9
    v_perm_b32 v113, v47, v45, s8
    v_perm_b32 v117, v47, v45, s9
L_w0:
    ds_read_b32 v154, v152 offset:12
    s_waitcnt lgkmcnt(0)
    v_readfirstlane_b32 s11, v154
    s_cmp_ge_u32 s11, 8
    s_cbranch_scc1 L_w0_done
    s_sleep 2
    s_sub_u32 s15, s15, 1
    s_cbranch_scc0 L_w0
    s_endpgm
L_w0_done:
    ds_read_b128 v[8:11], v7 offset:256
    ds_read_b128 v[12:15], v7 offset:272
    ds_read_b128 v[16:19], v7 offset:288
    ds_read_b128 v[20:23], v7 offset:304
    ds_read_b32 v27, v152 offset:24
    s_and_b32 s11, s3, 1
    s_lshl_b32 s11, s11, 2
    s_add_u32 s11, s11, s60
    v_add_u32 v28, s11, v1
    v_and_b32 v161, 3, v28
    v_lshlrev_b32 v161, 17, v161
    v_lshl_add_u32 v161, v3, 4, v161
    v_lshrrev_b32 v28, 2, v28
    s_add_u32 s60, s60, s4
    s_and_b32 s11, s60, 3
    s_lshl_b32 s11, s11, 17
    s_add_u32 s62, s62, s11
    s_waitcnt lgkmcnt(0)
    v_readfirstlane_b32 s11, v27
    v_xor_b32 v28, v28, v27
    v_and_b32 v28, 1, v28
    v_lshl_add_u32 v161, v28, 13, v161
    s_lshr_b32 s60, s60, 2
    s_xor_b32 s11, s11, s60
    s_and_b32 s11, s11, 1
    s_lshl_b32 s11, s11, 13
    s_add_u32 s62, s62, s11
    v_max3_f32 v24, v8, v10, v12
    v_max3_f32 v25, v14, v16, v18
    v_max3_f32 v24, v24, v20, v22
    v_max_f32 v24, v24, v25
    v_sub_f32 v8, v8, v24
    v_sub_f32 v10, v10, v24
    v_sub_f32 v12, v12, v24
    v_sub_f32 v14, v14, v24
    v_sub_f32 v16, v16, v24
    v_sub_f32 v18, v18, v24
    v_sub_f32 v20, v20, v24
    v_sub_f32 v22, v22, v24
    v_exp_f32 v8, v8
    v_exp_f32 v10, v10
    v_exp_f32 v12, v12
    v_exp_f32 v14, v14
    v_exp_f32 v16, v16
    v_exp_f32 v18, v18
    v_exp_f32 v20, v20
    v_exp_f32 v22, v22
    v_mul_f32 v25, v8, v9
    v_mul_f32 v26, v10, v11
    v_fmac_f32 v25, v12, v13
    v_fmac_f32 v26, v14, v15
    v_fmac_f32 v25, v16, v17
    v_fmac_f32 v26, v18, v19
    v_fmac_f32 v25, v20, v21
    v_fmac_f32 v26, v22, v23
    v_add_f32 v25, v25, v26
    v_rcp_f32 v25, v25
    s_nop 0
    v_mul_f32 v8, v8, v25
    v_mul_f32 v10, v10, v25
    v_mul_f32 v12, v12, v25
    v_mul_f32 v14, v14, v25
    v_mul_f32 v16, v16, v25
    v_mul_f32 v18, v18, v25
    v_mul_f32 v20, v20, v25
    v_mul_f32 v22, v22, v25
L_w1:
    ds_read_b32 v154, v152 offset:8
    s_waitcnt lgkmcnt(0)
    v_readfirstlane_b32 s11, v154
    s_cmp_ge_u32 s11, 8
    s_cbranch_scc1 L_w1_done
    s_sleep 1
    s_sub_u32 s15, s15, 1
    s_cbranch_scc0 L_w1
    s_endpgm
L_w1_done:
    s_add_u32 s11, s13, 131072
    buffer_load_dwordx2 v[48:49], v4, s[40:43], s11 offen offset:0 nt
    s_add_u32 s11, s13, 139264
    buffer_load_dwordx2 v[50:51], v4, s[40:43], s11 offen offset:0 nt
    s_add_u32 s11, s13, 147456
    buffer_load_dwordx2 v[52:53], v4, s[40:43], s11 offen offset:0 nt
    s_add_u32 s11, s13, 155648
    buffer_load_dwordx2 v[54:55], v4, s[40:43], s11 offen offset:0 nt
    buffer_load_dwordx2 v[56:57], v4, s[40:43], s13 offen offset:2048 nt
    s_add_u32 s11, s13, 8192
    buffer_load_dwordx2 v[58:59], v4, s[40:43], s11 offen offset:2048 nt
    s_add_u32 s11, s13, 16384
    buffer_load_dwordx2 v[60:61], v4, s[40:43], s11 offen offset:2048 nt
    s_add_u32 s11, s13, 24576
    buffer_load_dwordx2 v[62:63], v4, s[40:43], s11 offen offset:2048 nt
    s_add_u32 s11, s13, 131072
    buffer_load_dwordx2 v[64:65], v4, s[40:43], s11 offen offset:2048 nt
    s_add_u32 s11, s13, 139264
    buffer_load_dwordx2 v[66:67], v4, s[40:43], s11 offen offset:2048 nt
    s_add_u32 s11, s13, 147456
    buffer_load_dwordx2 v[68:69], v4, s[40:43], s11 offen offset:2048 nt
    s_add_u32 s11, s13, 155648
    buffer_load_dwordx2 v[70:71], v4, s[40:43], s11 offen offset:2048 nt
    s_cmp_eq_u32 s57, 1
    s_barrier
    ds_read_b64 v[24:25], v6 offset:1536
    ds_read_b64 v[26:27], v6 offset:3584
    ds_read_b64 v[28:29], v6 offset:5632
    ds_read_b64 v[30:31], v6 offset:7680
    ds_read_b64 v[32:33], v6 offset:9728
    ds_read_b64 v[34:35], v6 offset:11776
    ds_read_b64 v[36:37], v6 offset:13824
    ds_read_b64 v[38:39], v6 offset:15872
    s_waitcnt lgkmcnt(6)
    v_pk_mul_f32 v[72:73], v[24:25], v[8:9] op_sel_hi:[1,0]
    v_pk_mul_f32 v[74:75], v[26:27], v[10:11] op_sel_hi:[1,0]
    s_waitcnt lgkmcnt(4)
    v_pk_fma_f32 v[72:73], v[28:29], v[12:13], v[72:73] op_sel_hi:[1,0,1]
    v_pk_fma_f32 v[74:75], v[30:31], v[14:15], v[74:75] op_sel_hi:[1,0,1]
    s_waitcnt lgkmcnt(2)
    v_pk_fma_f32 v[72:73], v[32:33], v[16:17], v[72:73] op_sel_hi:[1,0,1]
    v_pk_fma_f32 v[74:75], v[34:35], v[18:19], v[74:75] op_sel_hi:[1,0,1]
    s_waitcnt lgkmcnt(0)
    v_pk_fma_f32 v[72:73], v[36:37], v[20:21], v[72:73] op_sel_hi:[1,0,1]
    v_pk_fma_f32 v[74:75], v[38:39], v[22:23], v[74:75] op_sel_hi:[1,0,1]
    v_pk_add_f32 v[72:73], v[72:73], v[74:75]
    v_cvt_pk_bf16_f32 v72, v72, v73
    v_min_u32 v72, -2, v72
    s_nop 1
    v_mov_b32_dpp v73, v72 quad_perm:[1,1,1,1] row_mask:0xf bank_mask:0xf
    v_mov_b32_dpp v74, v72 quad_perm:[2,2,2,2] row_mask:0xf bank_mask:0xf
    v_mov_b32_dpp v75, v72 quad_perm:[3,3,3,3] row_mask:0xf bank_mask:0xf
    s_mov_b64 exec, s[58:59]
    s_cbranch_scc0 L_oslow
    buffer_store_dwordx4 v[72:75], v160, s[44:47], s96 offen
    s_mov_b64 exec, -1
L_og:
    s_waitcnt vmcnt(11)
    v_perm_b32 v106, v50, v48, s8
    v_perm_b32 v110, v50, v48, s9
    v_perm_b32 v114, v51, v49, s8
    v_perm_b32 v118, v51, v49, s9
    s_waitcnt vmcnt(9)
    v_perm_b32 v107, v54, v52, s8
    v_perm_b32 v111, v54, v52, s9
    v_perm_b32 v115, v55, v53, s8
    v_perm_b32 v119, v55, v53, s9
    s_waitcnt vmcnt(7)
    v_perm_b32 v120, v58, v56, s8
    v_perm_b32 v124, v58, v56, s9
    v_perm_b32 v128, v59, v57, s8
    v_perm_b32 v132, v59, v57, s9
    buffer_load_dwordx4 v[136:139], v155, s[44:47], s10 offen sc1
    buffer_load_dwordx4 v[140:143], v155, s[44:47], s10 offen offset:1024 sc1
    s_waitcnt vmcnt(7)
    v_perm_b32 v121, v62, v60, s8
    v_perm_b32 v125, v62, v60, s9
    v_perm_b32 v129, v63, v61, s8
    v_perm_b32 v133, v63, v61, s9
    s_waitcnt vmcnt(5)
    v_perm_b32 v122, v66, v64, s8
    v_perm_b32 v126, v66, v64, s9
    v_perm_b32 v130, v67, v65, s8
    v_perm_b32 v134, v67, v65, s9
    s_waitcnt vmcnt(3)
    v_perm_b32 v123, v70, v68, s8
    v_perm_b32 v127, v70, v68, s9
    v_perm_b32 v131, v71, v69, s8
    v_perm_b32 v135, v71, v69, s9
    s_branch L_opw
L_op:
    buffer_load_dwordx4 v[136:139], v155, s[44:47], s10 offen sc1
    buffer_load_dwordx4 v[140:143], v155, s[44:47], s10 offen offset:1024 sc1
L_opw:
    s_waitcnt vmcnt(1)
    v_mfma_f32_16x16x32_bf16 v[8:11], v[104:107], v[136:139], 0
    v_max3_u32 v40, v136, v137, v138
    v_mfma_f32_16x16x32_bf16 v[12:15], v[108:111], v[136:139], 0
    s_waitcnt vmcnt(0)
    v_max3_u32 v41, v139, v140, v141
    v_max3_u32 v40, v40, v142, v143
    v_mfma_f32_16x16x32_bf16 v[16:19], v[112:115], v[136:139], 0
    v_max_u32 v40, v40, v41
    v_cmp_eq_u32 vcc, -1, v40
    v_mfma_f32_16x16x32_bf16 v[20:23], v[116:119], v[136:139], 0
    s_cbranch_vccnz L_op_retry
    v_mfma_f32_16x16x32_bf16 v[8:11], v[120:123], v[140:143], v[8:11]
    v_mfma_f32_16x16x32_bf16 v[12:15], v[124:127], v[140:143], v[12:15]
    v_mfma_f32_16x16x32_bf16 v[16:19], v[128:131], v[140:143], v[16:19]
    v_mfma_f32_16x16x32_bf16 v[20:23], v[132:135], v[140:143], v[20:23]
    s_nop 4
    ds_write_b128 v149, v[8:11] offset:17920
    ds_write_b128 v149, v[12:15] offset:17984
    ds_write_b128 v149, v[16:19] offset:18048
    ds_write_b128 v149, v[20:23] offset:18112
    s_waitcnt lgkmcnt(0)
    s_barrier
    ds_read_b128 v[24:27], v150 offset:17920
    ds_read_b128 v[28:31], v150 offset:22272
    ds_read_b128 v[32:35], v150 offset:26624
    ds_read_b128 v[36:39], v150 offset:30976
    s_waitcnt lgkmcnt(2)
    v_pk_add_f32 v[24:25], v[24:25], v[28:29]
    v_pk_add_f32 v[26:27], v[26:27], v[30:31]
    s_waitcnt lgkmcnt(1)
    v_pk_add_f32 v[24:25], v[24:25], v[32:33]
    v_pk_add_f32 v[26:27], v[26:27], v[34:35]
    s_waitcnt lgkmcnt(0)
    v_pk_add_f32 v[24:25], v[24:25], v[36:37]
    v_pk_add_f32 v[26:27], v[26:27], v[38:39]
    v_bfi_b32 v24, v148, s98, v24
    v_bfi_b32 v25, v148, s99, v25
    v_bfi_b32 v26, v148, s100, v26
    v_bfi_b32 v27, v148, s101, v27
    buffer_store_dwordx4 v[24:27], v161, s[44:47], s14 offen sc1
    s_cmp_lg_u32 s3, 0
    s_cbranch_scc1 L_end
    s_waitcnt vmcnt(0)
L_fp:
    buffer_load_dwordx4 v[8:11], v155, s[44:47], s62 offen offset:0 sc1
    buffer_load_dwordx4 v[12:15], v155, s[44:47], s62 offen offset:1024 sc1
    buffer_load_dwordx4 v[16:19], v155, s[44:47], s62 offen offset:2048 sc1
    buffer_load_dwordx4 v[20:23], v155, s[44:47], s62 offen offset:3072 sc1
    s_waitcnt vmcnt(3)
    v_xor_b32 v8, s98, v8
    v_xor_b32 v9, s99, v9
    v_xor_b32 v10, s100, v10
    v_xor_b32 v11, s101, v11
    v_or3_b32 v40, v8, v9, v10
    v_or_b32 v40, v40, v11
    s_waitcnt vmcnt(2)
    v_xor_b32 v12, s98, v12
    v_xor_b32 v13, s99, v13
    v_xor_b32 v14, s100, v14
    v_xor_b32 v15, s101, v15
    v_or3_b32 v40, v40, v12, v13
    v_or3_b32 v40, v40, v14, v15
    v_pk_add_f32 v[8:9], v[8:9], v[12:13]
    v_pk_add_f32 v[10:11], v[10:11], v[14:15]
    s_waitcnt vmcnt(1)
    v_xor_b32 v16, s98, v16
    v_xor_b32 v17, s99, v17
    v_xor_b32 v18, s100, v18
    v_xor_b32 v19, s101, v19
    v_or3_b32 v40, v40, v16, v17
    v_or3_b32 v40, v40, v18, v19
    v_pk_add_f32 v[8:9], v[8:9], v[16:17]
    v_pk_add_f32 v[10:11], v[10:11], v[18:19]
    s_waitcnt vmcnt(0)
    v_xor_b32 v20, s98, v20
    v_xor_b32 v21, s99, v21
    v_xor_b32 v22, s100, v22
    v_xor_b32 v23, s101, v23
    v_or3_b32 v40, v40, v20, v21
    v_or3_b32 v40, v40, v22, v23
    v_pk_add_f32 v[8:9], v[8:9], v[20:21]
    v_pk_add_f32 v[10:11], v[10:11], v[22:23]
    v_and_b32 v40, v40, v148
    v_cmp_ne_u32 vcc, 0, v40
    v_permlane32_swap_b32 v8, v10
    v_permlane32_swap_b32 v9, v11
    v_pk_add_f32 v[8:9], v[8:9], v[10:11]
    s_cbranch_vccnz L_fp_retry
    s_nop 0
    v_permlane16_swap_b32 v8, v9
    v_add_f32 v8, v8, v9
    v_cvt_pk_bf16_f32 v8, v8, v8
    buffer_store_short v8, v158, s[52:55], s12 offen
L_end:
    s_endpgm
L_op_retry:
    s_sub_u32 s15, s15, 1
    s_cbranch_scc0 L_op
    s_endpgm
L_fp_retry:
    s_sub_u32 s15, s15, 1
    s_cbranch_scc0 L_fp
    s_endpgm
L_oslow:
    s_add_u32 s96, s96, 0x200000
    s_add_u32 s10, s10, 0x200000
    buffer_store_dwordx4 v[72:75], v160, s[44:47], s96 offen sc1
    s_add_u32 s56, s61, 0x2c0000
    s_and_b32 s11, s5, 15
    s_lshl_b32 s11, s11, 2
    s_add_u32 s11, s11, s3
    s_lshl_b32 s11, s11, 2
    s_add_u32 s11, s11, s56
    s_waitcnt vmcnt(0)
    s_mov_b64 exec, 1
    buffer_store_dword v156, v152, s[44:47], s11 offen sc1
    s_mov_b64 exec, -1
    v_lshlrev_b32 v157, 2, v0
L_osp:
    s_sleep 4
    buffer_load_dword v154, v157, s[44:47], s56 offen sc1
    s_waitcnt vmcnt(0)
    v_cmp_ne_u32 vcc, v154, v156
    s_cbranch_vccz L_og
    s_sub_u32 s15, s15, 1
    s_cbranch_scc0 L_osp
    s_endpgm
L_qslow:
    s_add_u32 s63, s63, 0x200000
    s_add_u32 s62, s62, 0x200000
    buffer_store_dwordx4 v[164:167], v162, s[44:47], s63 offen sc1
    s_add_u32 s56, s61, 0x2c1000
    s_and_b32 s11, s5, 15
    s_lshl_b32 s11, s11, 2
    s_add_u32 s11, s11, s3
    s_lshl_b32 s11, s11, 2
    s_add_u32 s11, s11, s56
    s_waitcnt vmcnt(0)
    s_mov_b64 exec, 1
    buffer_store_dword v156, v152, s[44:47], s11 offen sc1
    s_mov_b64 exec, -1
    v_lshlrev_b32 v157, 2, v0
L_qsp:
    s_sleep 4
    buffer_load_dword v154, v157, s[44:47], s56 offen sc1
    s_waitcnt vmcnt(0)
    v_cmp_ne_u32 vcc, v154, v156
    s_cbranch_vccz L_qg
    s_sub_u32 s15, s15, 1
    s_cbranch_scc0 L_qsp
    s_endpgm
.section .rodata,"a"
.p2align 6
.amdhsa_kernel standalone__sliding_block_cached__sampling_kernel
  .amdhsa_next_free_vgpr 168
  .amdhsa_next_free_sgpr 102
  .amdhsa_accum_offset 168
  .amdhsa_group_segment_fixed_size 0
  .amdhsa_kernarg_size 64
  .amdhsa_user_sgpr_count 2
  .amdhsa_user_sgpr_kernarg_segment_ptr 1
  .amdhsa_system_sgpr_workgroup_id_x 1
.end_amdhsa_kernel
```
